```python
import torch

def _softmax(x, axis=-1):
    return torch.softmax(x, dim=axis)
def _gelu(x):
    return torch.nn.functional.gelu(x, approximate="tanh")
def _silu(x):
    return torch.nn.functional.silu(x)
def _sigmoid(x):
    return torch.sigmoid(x)
def _layernorm(x, axis=-1, eps=1e-5):
    m = x.mean(dim=axis, keepdim=True)
    v = x.var(dim=axis, keepdim=True, unbiased=False)
    return (x - m) / torch.sqrt(v + eps)
def _scatter_add(tgt, idx, src, axis=0):
    return tgt.clone().index_add_(axis, idx, src)
def _segment_sum(src, seg, n):
    out = torch.zeros((n,) + src.shape[1:], dtype=src.dtype)
    return out.index_add_(0, seg, src)
def _pad(x, pw):
    flat = tuple(v for pair in reversed(pw) for v in pair)
    return torch.nn.functional.pad(x, flat)

kernel_name = 'standalone__w8a8_smoothquant_per_tensor_per_channel_int8_activations_weights__sampling'

def setup_inputs():

    _w = (lambda a: (lambda t: t.to(torch.bfloat16) if t.is_floating_point() else t)(torch.as_tensor(a)))
    B, S, D, F = 32, 16, 1024, 3584
    x = abs((lambda *s: torch.randn(*s, dtype=torch.bfloat16) * 0.05)(B, S, D))
    w = (lambda *s: torch.randn(*s, dtype=torch.bfloat16) * 0.05)(D, F)
    x_min, x_max = float(x.min()), float(x.max())
    sx = (x_max - x_min) / 255.0 + 1e-6
    zx = int(torch.as_tensor(-128.0 - x_min / sx).round())
    qx = torch.clamp(torch.as_tensor(x / sx).round() + zx, -128, 127).to(torch.int32)
    sw = (torch.abs(w).amax(dim=0) / 127.0 + 1e-6).to(float)
    qw = torch.clamp(torch.as_tensor(w / sw[None, :]).round(), -127, 127).to(torch.int32)
    return {
        "qx": _w(qx),
        "qw": _w(qw),
        "scale_x": _w(torch.tensor(sx, dtype=float)),
        "zero_x": _w(torch.tensor(zx, dtype=torch.int32)),
        "scale_w": _w(sw),
        "bias": _w((lambda *s: torch.randn(*s, dtype=torch.bfloat16) * 0.05)(F)),
    }

def reference(qx, qw, scale_x, zero_x, scale_w, bias):
    dt = scale_w.dtype
    acc = torch.einsum("bsd,df->bsf", (lambda x, dt: x.to(dt))(qx, dt), (lambda x, dt: x.to(dt))(qw, dt))
    w_colsum = torch.sum((lambda x, dt: x.to(dt))(qw, dt), axis=0)
    acc = acc - (lambda x, dt: x.to(dt))(zero_x, dt) * w_colsum[None, None, :]
    return acc * scale_x * scale_w[None, None, :] + bias[None, None, :]
```

```asm
; @launch grid=(256,1,1) block=(1024,1,1) lds=66304
.amdgcn_target "amdgcn-amd-amdhsa--gfx950"
.text
.globl standalone__w8a8_smoothquant_per_tensor_per_channel_int8_activations_weights__sampling_kernel
.p2align 12
.p2align 8
.type standalone__w8a8_smoothquant_per_tensor_per_channel_int8_activations_weights__sampling_kernel,@function
standalone__w8a8_smoothquant_per_tensor_per_channel_int8_activations_weights__sampling_kernel:
    s_load_dwordx16 s[4:19], s[0:1], 0
    s_load_dwordx2 s[20:21], s[0:1], 64
    v_lshrrev_b32 v1, 6, v0
    v_and_b32 v0, 63, v0
    s_and_b32 s23, s2, 7
    v_readfirstlane_b32 s22, v1
    s_lshr_b32 s3, s2, 3
    s_cmp_ge_u32 s3, 4
    s_cbranch_scc1 L_cons
    s_lshl_b32 s71, s23, 2
    s_add_u32 s71, s71, s3
    s_lshl_b32 s68, s71, 4
    s_add_u32 s68, s68, s22
    s_lshl_b32 s69, s68, 12
    v_lshl_add_u32 v1, v0, 4, s69
    s_mov_b32 s30, 2097152
    s_mov_b32 s31, 0x20000
    s_waitcnt lgkmcnt(0)
    s_mov_b32 s28, s4
    s_mov_b32 s29, s5
    buffer_load_dwordx4 v[8:11], v1, s[28:31], 0 offen offset:0
    buffer_load_dwordx4 v[12:15], v1, s[28:31], 0 offen offset:1024
    buffer_load_dwordx4 v[16:19], v1, s[28:31], 0 offen offset:2048
    buffer_load_dwordx4 v[20:23], v1, s[28:31], 0 offen offset:3072
    s_branch L_prod2
L_cons:
    s_cmp_ge_u32 s3, 32
    s_cbranch_scc1 L_end
    v_mov_b32 v5, 65792
    s_cmp_lt_u32 s22, 4
    s_cbranch_scc1 L_pro
    v_mov_b32 v72, 0
    v_mov_b32 v73, 0
    v_lshlrev_b32 v6, 3, v0
    v_add_u32 v6, 65536, v6
    ds_write_b64 v6, v[72:73]
    s_waitcnt lgkmcnt(0)
    s_barrier
L_pro:
    s_lshr_b32 s74, s3, 2
    s_mul_i32 s64, s23, 7
    s_sub_u32 s64, s64, 1
    s_add_u32 s64, s64, s74
    s_and_b32 s3, s3, 3
    s_setprio 2
    s_bitcmp1_b32 s3, 0
    s_mov_b32 s58, 0x76543210
    s_mov_b32 s59, 0xfcebda98
    s_cselect_b32 s58, 0x21098765, s58
    s_cselect_b32 s59, 0xcfbead43, s59
    s_mov_b32 s60, 0x83726150
    s_mov_b32 s61, 0xfedcba94
    s_cselect_b32 s60, 0x38271605, s60
    s_cselect_b32 s61, 0xcbafed49, s61
    s_bitcmp1_b32 s3, 1
    s_cselect_b64 s[58:59], s[60:61], s[58:59]
    s_cselect_b32 s41, 12, 12
    s_and_b32 s69, s64, 3
    s_cmp_eq_u32 s69, 1
    s_cselect_b32 s69, s3, 0
    s_cselect_b32 s58, 0x76543210, s58
    s_cselect_b32 s59, 0xfedcba98, s59
    s_cselect_b32 s41, 12, s41
    s_xor_b32 s69, s69, s74
    s_and_b32 s69, s69, 3
    s_mul_i32 s69, s69, 0x44444444
    s_xor_b32 s40, s58, s69
    s_xor_b32 s75, s59, s69
    s_bitcmp1_b32 s22, 3
    s_cselect_b32 s68, s75, s40
    s_lshl_b32 s69, s22, 2
    s_lshr_b32 s68, s68, s69
    s_and_b32 s68, s68, 15
    v_lshrrev_b32 v2, 4, v0
    v_and_b32 v7, 15, v0
    v_mul_u32_u24 v2, 57344, v2
    v_lshl_add_u32 v2, v7, 4, v2
    s_lshl_b32 s70, s64, 8
    s_mul_i32 s68, s68, 229376
    s_add_u32 s68, s68, s70
    v_add_u32 v1, s68, v2
    v_add_u32 v2, 3670016, v1
    v_add_u32 v76, 7340032, v1
    v_add_u32 v77, 11010048, v1
    s_movk_i32 s49, 14336
    s_movk_i32 s50, 28672
    s_add_u32 s51, s49, s50
    s_mov_b32 s26, 14680064
    s_mov_b32 s27, 0x75fac
    s_cmp_lt_u32 s22, 4
    s_waitcnt lgkmcnt(0)
    s_mov_b32 s24, s6
    s_mov_b32 s25, s7
    s_cbranch_scc1 L_ld
    s_sub_u32 s69, s22, 4
L_tok:
    ds_read_b32 v6, v5 offset:20
    s_waitcnt lgkmcnt(0)
    v_readfirstlane_b32 s68, v6
    s_cmp_lt_u32 s68, s69
    s_cbranch_scc1 L_tok
    v_add_u32 v6, 1, v6
L_ld:
    buffer_load_format_d16_xyzw v[24:25], v1, s[24:27], 0 offen
    buffer_load_format_d16_xyzw v[26:27], v1, s[24:27], s49 offen
    buffer_load_format_d16_xyzw v[28:29], v1, s[24:27], s50 offen
    buffer_load_format_d16_xyzw v[30:31], v1, s[24:27], s51 offen
    s_cbranch_scc1 L_ld1
    ds_write_b32 v5, v6 offset:20
L_ld1:
    buffer_load_format_d16_xyzw v[32:33], v2, s[24:27], 0 offen
    buffer_load_format_d16_xyzw v[34:35], v2, s[24:27], s49 offen
    buffer_load_format_d16_xyzw v[36:37], v2, s[24:27], s50 offen
    buffer_load_format_d16_xyzw v[38:39], v2, s[24:27], s51 offen
    buffer_load_format_d16_xyzw v[40:41], v76, s[24:27], 0 offen
    buffer_load_format_d16_xyzw v[42:43], v76, s[24:27], s49 offen
    buffer_load_format_d16_xyzw v[44:45], v76, s[24:27], s50 offen
    buffer_load_format_d16_xyzw v[46:47], v76, s[24:27], s51 offen
    buffer_load_format_d16_xyzw v[48:49], v77, s[24:27], 0 offen
    buffer_load_format_d16_xyzw v[50:51], v77, s[24:27], s49 offen
    buffer_load_format_d16_xyzw v[52:53], v77, s[24:27], s50 offen
    buffer_load_format_d16_xyzw v[54:55], v77, s[24:27], s51 offen
    s_cbranch_scc0 L_ld2
    s_barrier
L_ld2:
    s_lshl_b32 s68, s3, 9
    s_lshl_b32 s69, s64, 3
    s_add_u32 s68, s68, s69
    s_add_u32 s68, s68, 1110016
    s_add_u32 s42, s20, s68
    s_addc_u32 s43, s21, 0
    s_lshl_b32 s69, s64, 7
    v_lshl_add_u32 v4, v7, 3, s69
    s_cmp_ge_u32 s22, 8
    s_cbranch_scc1 L_nopar
    s_load_dwordx2 s[46:47], s[42:43], 0
    s_load_dword s72, s[8:9], 0
    s_load_dword s73, s[10:11], 0
    s_cmp_lg_u32 s22, 0
    s_cbranch_scc1 L_nopar
    s_mov_b32 s36, s12
    s_mov_b32 s37, s13
    s_mov_b32 s38, 7168
    s_mov_b32 s39, 0x20000
    buffer_load_dwordx2 v[80:81], v4, s[36:39], 0 offen
    s_mov_b32 s36, s14
    s_mov_b32 s37, s15
    buffer_load_dwordx2 v[82:83], v4, s[36:39], 0 offen
L_nopar:
    s_mov_b32 s65, 0x06020400
    s_mov_b32 s66, 0x05040100
    s_mov_b32 s62, 0x07060302
    s_mov_b32 s67, 0x01010101
    v_lshlrev_b32 v3, 4, v0
    s_lshl_b32 s69, s22, 12
    v_add_u32 v1, s69, v3
    v_mov_b32 v72, 0
    v_mov_b32 v73, 0
    v_mov_b32 v74, 0
    v_mov_b32 v75, 0
    s_lshl_b32 s69, 1, s22
    v_mov_b32 v6, s69
    v_lshlrev_b32 v2, 4, v7
    v_add_u32 v2, 65536, v2
    s_waitcnt vmcnt(12) lgkmcnt(0)
    v_perm_b32 v24, v26, v24, s65
    v_perm_b32 v28, v30, v28, s65
    v_perm_b32 v25, v27, v25, s65
    v_perm_b32 v29, v31, v29, s65
    v_perm_b32 v8, v28, v24, s66
    v_perm_b32 v12, v28, v24, s62
    v_perm_b32 v16, v29, v25, s66
    v_perm_b32 v20, v29, v25, s62
    v_dot4c_i32_i8 v72, s67, v8
    v_dot4c_i32_i8 v73, s67, v12
    v_dot4c_i32_i8 v74, s67, v16
    v_dot4c_i32_i8 v75, s67, v20
    s_waitcnt vmcnt(8)
    v_perm_b32 v32, v34, v32, s65
    v_perm_b32 v36, v38, v36, s65
    v_perm_b32 v33, v35, v33, s65
    v_perm_b32 v37, v39, v37, s65
    v_perm_b32 v9, v36, v32, s66
    v_perm_b32 v13, v36, v32, s62
    v_perm_b32 v17, v37, v33, s66
    v_perm_b32 v21, v37, v33, s62
    v_dot4c_i32_i8 v72, s67, v9
    v_dot4c_i32_i8 v73, s67, v13
    v_dot4c_i32_i8 v74, s67, v17
    v_dot4c_i32_i8 v75, s67, v21
    s_waitcnt vmcnt(4)
    v_perm_b32 v40, v42, v40, s65
    v_perm_b32 v44, v46, v44, s65
    v_perm_b32 v41, v43, v41, s65
    v_perm_b32 v45, v47, v45, s65
    v_perm_b32 v10, v44, v40, s66
    v_perm_b32 v14, v44, v40, s62
    v_perm_b32 v18, v45, v41, s66
    v_perm_b32 v22, v45, v41, s62
    v_dot4c_i32_i8 v72, s67, v10
    v_dot4c_i32_i8 v73, s67, v14
    v_dot4c_i32_i8 v74, s67, v18
    v_dot4c_i32_i8 v75, s67, v22
    s_waitcnt vmcnt(0)
    v_perm_b32 v48, v50, v48, s65
    v_perm_b32 v52, v54, v52, s65
    v_perm_b32 v49, v51, v49, s65
    v_perm_b32 v53, v55, v53, s65
    v_perm_b32 v11, v52, v48, s66
    v_perm_b32 v15, v52, v48, s62
    v_perm_b32 v19, v53, v49, s66
    v_perm_b32 v23, v53, v49, s62
    ds_write_b128 v1, v[8:11] offset:0
    ds_write_b128 v1, v[12:15] offset:1024
    ds_write_b128 v1, v[16:19] offset:2048
    ds_write_b128 v1, v[20:23] offset:3072
    v_dot4c_i32_i8 v72, s67, v11
    v_dot4c_i32_i8 v73, s67, v15
    v_dot4c_i32_i8 v74, s67, v19
    v_dot4c_i32_i8 v75, s67, v23
    s_cmp_lg_u32 s22, 0
    s_cbranch_scc1 L_nopar2
    ds_write_b128 v2, v[80:83] offset:512
L_nopar2:
    s_nop 0
    ds_add_u32 v2, v72 offset:0
    ds_add_u32 v2, v73 offset:4
    ds_add_u32 v2, v74 offset:8
    ds_add_u32 v2, v75 offset:12
    s_mov_b64 exec, 1
    ds_or_b32 v5, v6
    s_mov_b64 exec, -1
    s_cmp_ge_u32 s22, 8
    s_cbranch_scc1 L_end
    s_setprio 0
    s_bfe_u32 s48, s40, 0x40000
    s_lshl_b32 s48, s48, 10
    s_bfe_u32 s49, s40, 0x40004
    s_lshl_b32 s49, s49, 10
    s_bfe_u32 s50, s40, 0x40008
    s_lshl_b32 s50, s50, 10
    s_bfe_u32 s51, s40, 0x4000c
    s_lshl_b32 s51, s51, 10
    s_bfe_u32 s52, s40, 0x40010
    s_lshl_b32 s52, s52, 10
    s_bfe_u32 s53, s40, 0x40014
    s_lshl_b32 s53, s53, 10
    s_bfe_u32 s54, s40, 0x40018
    s_lshl_b32 s54, s54, 10
    s_bfe_u32 s55, s40, 0x4001c
    s_lshl_b32 s55, s55, 10
    s_bfe_u32 s56, s75, 0x40000
    s_lshl_b32 s56, s56, 10
    s_bfe_u32 s57, s75, 0x40004
    s_lshl_b32 s57, s57, 10
    s_bfe_u32 s58, s75, 0x40008
    s_lshl_b32 s58, s58, 10
    s_bfe_u32 s59, s75, 0x4000c
    s_lshl_b32 s59, s59, 10
    s_bfe_u32 s60, s75, 0x40010
    s_lshl_b32 s60, s60, 10
    s_bfe_u32 s61, s75, 0x40014
    s_lshl_b32 s61, s61, 10
    s_bfe_u32 s62, s75, 0x40018
    s_lshl_b32 s62, s62, 10
    s_bfe_u32 s63, s75, 0x4001c
    s_lshl_b32 s63, s63, 10
    s_lshl_b32 s68, s3, 3
    s_add_u32 s71, s22, s68
    s_lshl_b32 s70, s64, 2
    s_add_u32 s70, s70, s3
    s_mul_i32 s70, s70, 4352
    s_add_u32 s70, s70, 1114112
    s_add_u32 s44, s20, s70
    s_addc_u32 s45, s21, 0
    s_lshl_b32 s70, s71, 14
    v_add_u32 v1, s70, v3
    s_mul_i32 s70, s71, 114688
    v_lshrrev_b32 v7, 4, v0
    v_mul_u32_u24 v7, 28672, v7
    v_add3_u32 v7, v7, v4, s70
    s_mov_b32 s28, s20
    s_mov_b32 s29, s21
    s_mov_b32 s30, 1048576
    s_mov_b32 s31, 0x20000
    s_mov_b32 s32, s16
    s_mov_b32 s33, s17
    s_mov_b32 s34, 3670016
    s_mov_b32 s35, 0x20000
    s_movk_i32 s37, 7168
    s_movk_i32 s38, 14336
    s_movk_i32 s39, 21504
    s_waitcnt lgkmcnt(0)
    v_mov_b32 v76, 0
    v_mov_b32 v77, 0
    v_mov_b32 v78, 0
    v_mov_b32 v79, 0
    v_mov_b32 v80, 0
    v_mov_b32 v81, 0
    v_mov_b32 v82, 0
    v_mov_b32 v83, 0
    v_mov_b32 v84, 0
    v_mov_b32 v85, 0
    v_mov_b32 v86, 0
    v_mov_b32 v87, 0
    v_mov_b32 v88, 0
    v_mov_b32 v89, 0
    v_mov_b32 v90, 0
    v_mov_b32 v91, 0
    s_mul_i32 s46, s46, 2654435761
    s_add_u32 s46, s46, 2135587861
    s_mul_i32 s47, s47, 2246822507
    s_add_u32 s47, s47, 374761393
    s_lshl_b32 s72, s72, 16
    v_cvt_f32_i32 v108, s73
    v_cvt_pk_bf16_f32 v108, 0, v108
L_w0:
    s_sleep 1
    ds_read_b32 v6, v5
    s_waitcnt lgkmcnt(0)
    v_readfirstlane_b32 s26, v6
    s_andn2_b32 s68, 0x7, s26
    s_cbranch_scc1 L_w0
    ds_read_b128 v[104:107], v2 offset:512
    ds_read_b128 v[28:31], v3 offset:0
    ds_read_b128 v[32:35], v3 offset:1024
    ds_read_b128 v[36:39], v3 offset:2048
    ds_read_b128 v[40:43], v3 offset:3072
    ds_read_b128 v[44:47], v3 offset:4096
    ds_read_b128 v[48:51], v3 offset:5120
    ds_read_b128 v[52:55], v3 offset:6144
    ds_read_b128 v[56:59], v3 offset:7168
    ds_read_b128 v[60:63], v3 offset:8192
    ds_read_b128 v[64:67], v3 offset:9216
    ds_read_b128 v[68:71], v3 offset:10240
    ds_read_b128 v[72:75], v3 offset:11264
    s_waitcnt lgkmcnt(0)
    v_lshlrev_b32 v96, 16, v104
    v_and_b32 v97, 0xffff0000, v104
    v_lshlrev_b32 v98, 16, v105
    v_and_b32 v99, 0xffff0000, v105
    v_lshlrev_b32 v100, 16, v106
    v_and_b32 v101, 0xffff0000, v106
    v_lshlrev_b32 v102, 16, v107
    v_and_b32 v103, 0xffff0000, v107
    v_mul_f32 v96, s72, v96
    v_mul_f32 v97, s72, v97
    v_mul_f32 v98, s72, v98
    v_mul_f32 v99, s72, v99
    s_cmp_ge_u32 s22, 2
    s_cbranch_scc1 L_go
    s_mov_b32 s69, 0
L_poll:
    s_load_dwordx16 s[4:19], s[44:45], 0 glc
    s_add_u32 s69, s69, 1
    s_bitcmp1_b32 s69, 20
    s_cbranch_scc1 L_polldone
    s_waitcnt lgkmcnt(0)
    s_xor_b64 s[4:5], s[4:5], s[46:47]
    s_xor_b64 s[6:7], s[6:7], s[46:47]
    s_xor_b64 s[8:9], s[8:9], s[46:47]
    s_xor_b64 s[10:11], s[10:11], s[46:47]
    s_xor_b64 s[12:13], s[12:13], s[46:47]
    s_xor_b64 s[14:15], s[14:15], s[46:47]
    s_xor_b64 s[16:17], s[16:17], s[46:47]
    s_xor_b64 s[18:19], s[18:19], s[46:47]
    s_or_b64 s[4:5], s[4:5], s[6:7]
    s_or_b64 s[4:5], s[4:5], s[8:9]
    s_or_b64 s[4:5], s[4:5], s[10:11]
    s_or_b64 s[4:5], s[4:5], s[12:13]
    s_or_b64 s[4:5], s[4:5], s[14:15]
    s_or_b64 s[4:5], s[4:5], s[16:17]
    s_or_b64 s[4:5], s[4:5], s[18:19]
    s_cbranch_scc1 L_poll
L_polldone:
    v_mov_b32 v6, 1
    ds_write_b32 v5, v6 offset:16
L_go:
    ds_read_b64 v[104:105], v5 offset:16
    s_waitcnt lgkmcnt(0)
    v_mul_u32_u24 v104, v104, v105
    s_nop 0
    v_readfirstlane_b32 s68, v104
    s_cmp_lt_u32 s68, s41
    s_cbranch_scc1 L_go
    ds_read_b32 v6, v5
    buffer_load_dwordx4 v[8:11], v1, s[28:31], s48 offen sc1
    buffer_load_dwordx4 v[12:15], v1, s[28:31], s49 offen sc1
    buffer_load_dwordx4 v[16:19], v1, s[28:31], s50 offen sc1
    buffer_load_dwordx4 v[20:23], v1, s[28:31], s51 offen sc1
    s_waitcnt lgkmcnt(0)
    v_readfirstlane_b32 s26, v6
    s_waitcnt vmcnt(3)
    buffer_load_dwordx4 v[24:27], v1, s[28:31], s52 offen sc1
    v_mfma_i32_16x16x64_i8 v[76:79], v[8:11], v[28:31], v[76:79]
    v_mfma_i32_16x16x64_i8 v[80:83], v[8:11], v[32:35], v[80:83]
    v_mfma_i32_16x16x64_i8 v[84:87], v[8:11], v[36:39], v[84:87]
    v_mfma_i32_16x16x64_i8 v[88:91], v[8:11], v[40:43], v[88:91]
    s_andn2_b32 s68, 0xff8, s26
    s_cbranch_scc0 L_ok3
L_wt3:
    ds_read_b32 v6, v5
    s_waitcnt lgkmcnt(0)
    v_readfirstlane_b32 s26, v6
    s_andn2_b32 s68, 0xff8, s26
    s_cbranch_scc1 L_wt3
L_ok3:
    ds_read_b128 v[28:31], v3 offset:12288
    ds_read_b128 v[32:35], v3 offset:13312
    ds_read_b128 v[36:39], v3 offset:14336
    ds_read_b128 v[40:43], v3 offset:15360
    s_waitcnt vmcnt(3)
    buffer_load_dwordx4 v[8:11], v1, s[28:31], s53 offen sc1
    v_mfma_i32_16x16x64_i8 v[76:79], v[12:15], v[44:47], v[76:79]
    ds_read_b128 v[44:47], v3 offset:16384
    v_mfma_i32_16x16x64_i8 v[80:83], v[12:15], v[48:51], v[80:83]
    ds_read_b128 v[48:51], v3 offset:17408
    v_mfma_i32_16x16x64_i8 v[84:87], v[12:15], v[52:55], v[84:87]
    ds_read_b128 v[52:55], v3 offset:18432
    v_mfma_i32_16x16x64_i8 v[88:91], v[12:15], v[56:59], v[88:91]
    ds_read_b128 v[56:59], v3 offset:19456
    s_waitcnt vmcnt(3)
    buffer_load_dwordx4 v[12:15], v1, s[28:31], s54 offen sc1
    v_mfma_i32_16x16x64_i8 v[76:79], v[16:19], v[60:63], v[76:79]
    ds_read_b128 v[60:63], v3 offset:20480
    v_mfma_i32_16x16x64_i8 v[80:83], v[16:19], v[64:67], v[80:83]
    ds_read_b128 v[64:67], v3 offset:21504
    v_mfma_i32_16x16x64_i8 v[84:87], v[16:19], v[68:71], v[84:87]
    ds_read_b128 v[68:71], v3 offset:22528
    v_mfma_i32_16x16x64_i8 v[88:91], v[16:19], v[72:75], v[88:91]
    ds_read_b128 v[72:75], v3 offset:23552
    s_waitcnt vmcnt(3) lgkmcnt(8)
    buffer_load_dwordx4 v[16:19], v1, s[28:31], s55 offen sc1
    v_mfma_i32_16x16x64_i8 v[76:79], v[20:23], v[28:31], v[76:79]
    ds_read_b128 v[28:31], v3 offset:24576
    v_mfma_i32_16x16x64_i8 v[80:83], v[20:23], v[32:35], v[80:83]
    ds_read_b128 v[32:35], v3 offset:25600
    v_mfma_i32_16x16x64_i8 v[84:87], v[20:23], v[36:39], v[84:87]
    ds_read_b128 v[36:39], v3 offset:26624
    v_mfma_i32_16x16x64_i8 v[88:91], v[20:23], v[40:43], v[88:91]
    ds_read_b128 v[40:43], v3 offset:27648
    s_waitcnt vmcnt(3) lgkmcnt(8)
    buffer_load_dwordx4 v[20:23], v1, s[28:31], s56 offen sc1
    v_mfma_i32_16x16x64_i8 v[76:79], v[24:27], v[44:47], v[76:79]
    ds_read_b128 v[44:47], v3 offset:28672
    v_mfma_i32_16x16x64_i8 v[80:83], v[24:27], v[48:51], v[80:83]
    ds_read_b128 v[48:51], v3 offset:29696
    v_mfma_i32_16x16x64_i8 v[84:87], v[24:27], v[52:55], v[84:87]
    ds_read_b128 v[52:55], v3 offset:30720
    v_mfma_i32_16x16x64_i8 v[88:91], v[24:27], v[56:59], v[88:91]
    ds_read_b128 v[56:59], v3 offset:31744
    s_waitcnt vmcnt(3) lgkmcnt(8)
    buffer_load_dwordx4 v[24:27], v1, s[28:31], s57 offen sc1
    v_mfma_i32_16x16x64_i8 v[76:79], v[8:11], v[60:63], v[76:79]
    ds_read_b128 v[60:63], v3 offset:32768
    v_mfma_i32_16x16x64_i8 v[80:83], v[8:11], v[64:67], v[80:83]
    ds_read_b128 v[64:67], v3 offset:33792
    v_mfma_i32_16x16x64_i8 v[84:87], v[8:11], v[68:71], v[84:87]
    ds_read_b128 v[68:71], v3 offset:34816
    v_mfma_i32_16x16x64_i8 v[88:91], v[8:11], v[72:75], v[88:91]
    ds_read_b128 v[72:75], v3 offset:35840
    s_waitcnt vmcnt(3) lgkmcnt(8)
    buffer_load_dwordx4 v[8:11], v1, s[28:31], s58 offen sc1
    v_mfma_i32_16x16x64_i8 v[76:79], v[12:15], v[28:31], v[76:79]
    v_mfma_i32_16x16x64_i8 v[80:83], v[12:15], v[32:35], v[80:83]
    v_mfma_i32_16x16x64_i8 v[84:87], v[12:15], v[36:39], v[84:87]
    v_mfma_i32_16x16x64_i8 v[88:91], v[12:15], v[40:43], v[88:91]
    ds_read_b32 v6, v5
    ds_read_b128 v[28:31], v3 offset:36864
    ds_read_b128 v[32:35], v3 offset:37888
    ds_read_b128 v[36:39], v3 offset:38912
    ds_read_b128 v[40:43], v3 offset:39936
    s_waitcnt vmcnt(3) lgkmcnt(9)
    buffer_load_dwordx4 v[12:15], v1, s[28:31], s59 offen sc1
    v_mfma_i32_16x16x64_i8 v[76:79], v[16:19], v[44:47], v[76:79]
    ds_read_b128 v[44:47], v3 offset:40960
    v_mfma_i32_16x16x64_i8 v[80:83], v[16:19], v[48:51], v[80:83]
    ds_read_b128 v[48:51], v3 offset:41984
    v_mfma_i32_16x16x64_i8 v[84:87], v[16:19], v[52:55], v[84:87]
    ds_read_b128 v[52:55], v3 offset:43008
    v_mfma_i32_16x16x64_i8 v[88:91], v[16:19], v[56:59], v[88:91]
    ds_read_b128 v[56:59], v3 offset:44032
    s_waitcnt vmcnt(3) lgkmcnt(9)
    buffer_load_dwordx4 v[16:19], v1, s[28:31], s60 offen sc1
    v_mfma_i32_16x16x64_i8 v[76:79], v[20:23], v[60:63], v[76:79]
    ds_read_b128 v[60:63], v3 offset:45056
    v_mfma_i32_16x16x64_i8 v[80:83], v[20:23], v[64:67], v[80:83]
    ds_read_b128 v[64:67], v3 offset:46080
    v_mfma_i32_16x16x64_i8 v[84:87], v[20:23], v[68:71], v[84:87]
    ds_read_b128 v[68:71], v3 offset:47104
    v_mfma_i32_16x16x64_i8 v[88:91], v[20:23], v[72:75], v[88:91]
    ds_read_b128 v[72:75], v3 offset:48128
    s_waitcnt vmcnt(3) lgkmcnt(8)
    v_readfirstlane_b32 s26, v6
    buffer_load_dwordx4 v[20:23], v1, s[28:31], s61 offen sc1
    v_mfma_i32_16x16x64_i8 v[76:79], v[24:27], v[28:31], v[76:79]
    v_mfma_i32_16x16x64_i8 v[80:83], v[24:27], v[32:35], v[80:83]
    v_mfma_i32_16x16x64_i8 v[84:87], v[24:27], v[36:39], v[84:87]
    v_mfma_i32_16x16x64_i8 v[88:91], v[24:27], v[40:43], v[88:91]
    s_andn2_b32 s68, 0xf000, s26
    s_cbranch_scc0 L_ok12
L_wt12:
    ds_read_b32 v6, v5
    s_waitcnt lgkmcnt(0)
    v_readfirstlane_b32 s26, v6
    s_andn2_b32 s68, 0xf000, s26
    s_cbranch_scc1 L_wt12
L_ok12:
    ds_read_b128 v[92:95], v2
    ds_read_b128 v[28:31], v3 offset:49152
    ds_read_b128 v[32:35], v3 offset:50176
    ds_read_b128 v[36:39], v3 offset:51200
    ds_read_b128 v[40:43], v3 offset:52224
    s_waitcnt vmcnt(3) lgkmcnt(9)
    buffer_load_dwordx4 v[24:27], v1, s[28:31], s62 offen sc1
    v_mfma_i32_16x16x64_i8 v[76:79], v[8:11], v[44:47], v[76:79]
    ds_read_b128 v[44:47], v3 offset:53248
    v_mfma_i32_16x16x64_i8 v[80:83], v[8:11], v[48:51], v[80:83]
    ds_read_b128 v[48:51], v3 offset:54272
    v_mfma_i32_16x16x64_i8 v[84:87], v[8:11], v[52:55], v[84:87]
    ds_read_b128 v[52:55], v3 offset:55296
    v_mfma_i32_16x16x64_i8 v[88:91], v[8:11], v[56:59], v[88:91]
    ds_read_b128 v[56:59], v3 offset:56320
    s_waitcnt vmcnt(3) lgkmcnt(9)
    buffer_load_dwordx4 v[8:11], v1, s[28:31], s63 offen sc1
    v_mfma_i32_16x16x64_i8 v[76:79], v[12:15], v[60:63], v[76:79]
    ds_read_b128 v[60:63], v3 offset:57344
    v_mfma_i32_16x16x64_i8 v[80:83], v[12:15], v[64:67], v[80:83]
    ds_read_b128 v[64:67], v3 offset:58368
    v_mfma_i32_16x16x64_i8 v[84:87], v[12:15], v[68:71], v[84:87]
    ds_read_b128 v[68:71], v3 offset:59392
    v_mfma_i32_16x16x64_i8 v[88:91], v[12:15], v[72:75], v[88:91]
    ds_read_b128 v[72:75], v3 offset:60416
    s_waitcnt vmcnt(3) lgkmcnt(8)
    v_mfma_i32_16x16x64_i8 v[76:79], v[16:19], v[28:31], v[76:79]
    ds_read_b128 v[28:31], v3 offset:61440
    v_mfma_i32_16x16x64_i8 v[80:83], v[16:19], v[32:35], v[80:83]
    ds_read_b128 v[32:35], v3 offset:62464
    v_mfma_i32_16x16x64_i8 v[84:87], v[16:19], v[36:39], v[84:87]
    ds_read_b128 v[36:39], v3 offset:63488
    v_mfma_i32_16x16x64_i8 v[88:91], v[16:19], v[40:43], v[88:91]
    ds_read_b128 v[40:43], v3 offset:64512
    v_cvt_f32_i32 v92, v92
    v_cvt_f32_i32 v93, v93
    v_cvt_f32_i32 v94, v94
    v_cvt_f32_i32 v95, v95
    v_cvt_pk_bf16_f32 v92, 0, v92
    v_cvt_pk_bf16_f32 v93, 0, v93
    v_cvt_pk_bf16_f32 v94, 0, v94
    v_cvt_pk_bf16_f32 v95, 0, v95
    v_mul_f32 v92, v108, v92
    v_mul_f32 v93, v108, v93
    v_mul_f32 v94, v108, v94
    v_mul_f32 v95, v108, v95
    v_cvt_pk_bf16_f32 v92, 0, v92
    v_cvt_pk_bf16_f32 v93, 0, v93
    v_cvt_pk_bf16_f32 v94, 0, v94
    v_cvt_pk_bf16_f32 v95, 0, v95
    v_fma_f32 v100, -v92, v96, v100
    v_fma_f32 v101, -v93, v97, v101
    v_fma_f32 v102, -v94, v98, v102
    v_fma_f32 v103, -v95, v99, v103
    v_mov_b32 v104, s46
    v_mov_b32 v105, s47
    v_mov_b32 v106, 0
    s_waitcnt vmcnt(2) lgkmcnt(8)
    v_mfma_i32_16x16x64_i8 v[76:79], v[20:23], v[44:47], v[76:79]
    v_mfma_i32_16x16x64_i8 v[80:83], v[20:23], v[48:51], v[80:83]
    v_mfma_i32_16x16x64_i8 v[84:87], v[20:23], v[52:55], v[84:87]
    v_mfma_i32_16x16x64_i8 v[88:91], v[20:23], v[56:59], v[88:91]
    s_waitcnt vmcnt(1) lgkmcnt(4)
    v_mfma_i32_16x16x64_i8 v[76:79], v[24:27], v[60:63], v[76:79]
    v_mfma_i32_16x16x64_i8 v[80:83], v[24:27], v[64:67], v[80:83]
    v_mfma_i32_16x16x64_i8 v[84:87], v[24:27], v[68:71], v[84:87]
    v_mfma_i32_16x16x64_i8 v[88:91], v[24:27], v[72:75], v[88:91]
    s_waitcnt vmcnt(0) lgkmcnt(0)
    v_mfma_i32_16x16x64_i8 v[76:79], v[8:11], v[28:31], v[76:79]
    v_mfma_i32_16x16x64_i8 v[80:83], v[8:11], v[32:35], v[80:83]
    v_mfma_i32_16x16x64_i8 v[84:87], v[8:11], v[36:39], v[84:87]
    v_mfma_i32_16x16x64_i8 v[88:91], v[8:11], v[40:43], v[88:91]
    s_cmp_lg_u32 s22, 0
    s_cbranch_scc1 L_nobump
    s_mov_b64 exec, 1
    global_store_dwordx2 v106, v[104:105], s[42:43] sc1
    s_mov_b64 exec, -1
L_nobump:
    s_nop 5
    v_cvt_f32_i32 v76, v76
    v_cvt_f32_i32 v77, v77
    v_cvt_f32_i32 v80, v80
    v_cvt_f32_i32 v81, v81
    v_cvt_f32_i32 v84, v84
    v_cvt_f32_i32 v85, v85
    v_cvt_f32_i32 v88, v88
    v_cvt_f32_i32 v89, v89
    v_cvt_pk_bf16_f32 v76, 0, v76
    v_cvt_pk_bf16_f32 v77, 0, v77
    v_cvt_pk_bf16_f32 v80, 0, v80
    v_cvt_pk_bf16_f32 v81, 0, v81
    v_cvt_pk_bf16_f32 v84, 0, v84
    v_cvt_pk_bf16_f32 v85, 0, v85
    v_cvt_pk_bf16_f32 v88, 0, v88
    v_cvt_pk_bf16_f32 v89, 0, v89
    v_pk_fma_f32 v[76:77], v[76:77], v[96:97], v[100:101] op_sel:[0,0,0] op_sel_hi:[1,0,0]
    v_pk_fma_f32 v[80:81], v[80:81], v[96:97], v[100:101] op_sel:[0,1,1] op_sel_hi:[1,1,1]
    v_pk_fma_f32 v[84:85], v[84:85], v[98:99], v[102:103] op_sel:[0,0,0] op_sel_hi:[1,0,0]
    v_pk_fma_f32 v[88:89], v[88:89], v[98:99], v[102:103] op_sel:[0,1,1] op_sel_hi:[1,1,1]
    v_cvt_pk_bf16_f32 v8, v76, v80
    v_cvt_pk_bf16_f32 v9, v84, v88
    buffer_store_dwordx2 v[8:9], v7, s[32:35], 0 offen nt
    v_cvt_pk_bf16_f32 v10, v77, v81
    v_cvt_pk_bf16_f32 v11, v85, v89
    buffer_store_dwordx2 v[10:11], v7, s[32:35], s37 offen nt
    v_cvt_f32_i32 v78, v78
    v_cvt_f32_i32 v79, v79
    v_cvt_f32_i32 v82, v82
    v_cvt_f32_i32 v83, v83
    v_cvt_f32_i32 v86, v86
    v_cvt_f32_i32 v87, v87
    v_cvt_f32_i32 v90, v90
    v_cvt_f32_i32 v91, v91
    v_cvt_pk_bf16_f32 v78, 0, v78
    v_cvt_pk_bf16_f32 v79, 0, v79
    v_cvt_pk_bf16_f32 v82, 0, v82
    v_cvt_pk_bf16_f32 v83, 0, v83
    v_cvt_pk_bf16_f32 v86, 0, v86
    v_cvt_pk_bf16_f32 v87, 0, v87
    v_cvt_pk_bf16_f32 v90, 0, v90
    v_cvt_pk_bf16_f32 v91, 0, v91
    v_pk_fma_f32 v[78:79], v[78:79], v[96:97], v[100:101] op_sel:[0,0,0] op_sel_hi:[1,0,0]
    v_pk_fma_f32 v[82:83], v[82:83], v[96:97], v[100:101] op_sel:[0,1,1] op_sel_hi:[1,1,1]
    v_pk_fma_f32 v[86:87], v[86:87], v[98:99], v[102:103] op_sel:[0,0,0] op_sel_hi:[1,0,0]
    v_pk_fma_f32 v[90:91], v[90:91], v[98:99], v[102:103] op_sel:[0,1,1] op_sel_hi:[1,1,1]
    v_cvt_pk_bf16_f32 v12, v78, v82
    v_cvt_pk_bf16_f32 v13, v86, v90
    buffer_store_dwordx2 v[12:13], v7, s[32:35], s38 offen nt
    v_cvt_pk_bf16_f32 v14, v79, v83
    v_cvt_pk_bf16_f32 v15, v87, v91
    buffer_store_dwordx2 v[14:15], v7, s[32:35], s39 offen nt
L_end:
    s_endpgm
.p2align 12
L_prod2:
    s_mov_b32 s65, 0x0c0c0400
    s_mov_b32 s66, 0x04000c0c
    s_mov_b32 s32, s20
    s_mov_b32 s33, s21
    s_mov_b32 s34, 2088960
    s_mov_b32 s35, 0x20000
    s_lshr_b32 s3, s71, 3
    s_lshl_b32 s70, s3, 9
    s_add_u32 s70, s70, 1110016
    v_lshl_add_u32 v6, v0, 3, s70
    s_mul_i32 s69, s3, 4352
    s_and_b32 s70, s71, 7
    s_lshl_b32 s70, s70, 3
    s_add_u32 s69, s69, s70
    s_add_u32 s69, s69, 1114112
    v_mul_u32_u24 v7, 17408, v0
    v_add_u32 v7, s69, v7
    s_cmp_lg_u32 s22, 0
    s_cbranch_scc1 L_prod3
    buffer_load_dwordx2 v[32:33], v6, s[32:35], 0 offen
L_prod3:
    s_lshl_b32 s69, s68, 10
    v_lshl_add_u32 v2, v0, 4, s69
    v_mul_u32_u24 v3, 272, v0
    s_lshl_b32 s69, s22, 4
    v_add_u32 v3, s69, v3
    v_lshrrev_b32 v4, 4, v0
    v_and_b32 v5, 15, v0
    s_lshl_b32 s69, s22, 2
    v_add_u32 v4, s69, v4
    v_mul_u32_u24 v4, 272, v4
    v_lshl_add_u32 v4, v5, 4, v4
    s_mov_b32 s69, 2654435761
    s_mov_b32 s70, 2246822507
    s_waitcnt vmcnt(3)
    v_perm_b32 v8, v9, v8, s65
    v_perm_b32 v10, v11, v10, s66
    v_or_b32 v24, v8, v10
    s_waitcnt vmcnt(2)
    v_perm_b32 v12, v13, v12, s65
    v_perm_b32 v14, v15, v14, s66
    v_or_b32 v25, v12, v14
    s_waitcnt vmcnt(1)
    v_perm_b32 v16, v17, v16, s65
    v_perm_b32 v18, v19, v18, s66
    v_or_b32 v26, v16, v18
    s_waitcnt vmcnt(0)
    v_perm_b32 v20, v21, v20, s65
    v_perm_b32 v22, v23, v22, s66
    v_or_b32 v27, v20, v22
    ds_write_b128 v3, v[24:27]
    v_mul_lo_u32 v32, v32, s69
    v_mul_lo_u32 v33, v33, s70
    v_add_u32 v32, 2135587861, v32
    v_add_u32 v33, 374761393, v33
    s_waitcnt lgkmcnt(0)
    s_barrier
    ds_read_b128 v[28:31], v4
    s_waitcnt lgkmcnt(0)
    buffer_store_dwordx4 v[28:31], v2, s[32:35], 0 offen sc1
    s_waitcnt vmcnt(0)
    s_barrier
    s_cmp_lg_u32 s22, 0
    s_cbranch_scc1 L_pend
    buffer_store_dwordx2 v[32:33], v7, s[32:35], 0 offen sc1
L_pend:
    s_endpgm
.section .rodata,"a"
.p2align 6
.amdhsa_kernel standalone__w8a8_smoothquant_per_tensor_per_channel_int8_activations_weights__sampling_kernel
  .amdhsa_next_free_vgpr 128
  .amdhsa_next_free_sgpr 100
  .amdhsa_accum_offset 128
  .amdhsa_group_segment_fixed_size 0
  .amdhsa_kernarg_size 72
  .amdhsa_user_sgpr_count 2
  .amdhsa_user_sgpr_kernarg_segment_ptr 1
  .amdhsa_system_sgpr_workgroup_id_x 1
  .amdhsa_float_denorm_mode_32 3
.end_amdhsa_kernel
```
